```python
import torch

def _softmax(x, axis=-1):
    return torch.softmax(x, dim=axis)
def _gelu(x):
    return torch.nn.functional.gelu(x, approximate="tanh")
def _silu(x):
    return torch.nn.functional.silu(x)
def _sigmoid(x):
    return torch.sigmoid(x)
def _layernorm(x, axis=-1, eps=1e-5):
    m = x.mean(dim=axis, keepdim=True)
    v = x.var(dim=axis, keepdim=True, unbiased=False)
    return (x - m) / torch.sqrt(v + eps)
def _scatter_add(tgt, idx, src, axis=0):
    return tgt.clone().index_add_(axis, idx, src)
def _segment_sum(src, seg, n):
    out = torch.zeros((n,) + src.shape[1:], dtype=src.dtype)
    return out.index_add_(0, seg, src)
def _pad(x, pw):
    flat = tuple(v for pair in reversed(pw) for v in pair)
    return torch.nn.functional.pad(x, flat)

kernel_name = 'standalone__deepnorm__sampling'

def setup_inputs():

    _w = (lambda a: (lambda t: t.to(torch.bfloat16) if t.is_floating_point() else t)(torch.as_tensor(a)))
    B, S, D = 1024, 32, 448
    return {
        "x": _w((lambda *s: torch.randn(*s, dtype=torch.bfloat16) * 0.05)(B, S, D)),
        "f": _w((lambda *s: torch.randn(*s, dtype=torch.bfloat16) * 0.05)(B, S, D)),
        "g": _w((lambda *s: torch.randn(*s, dtype=torch.bfloat16) * 0.05)(D) + 1.0),
        "b": _w((lambda *s: torch.randn(*s, dtype=torch.bfloat16) * 0.4)(D)),
        "alpha": _w(float(2.0)),
    }

def reference(x, f, g, b, alpha):
    return _layernorm(alpha * x + f, axis=-1) * g + b
```

```asm
; @launch grid=(256,1,1) block=(1024,1,1) lds=0
.amdgcn_target "amdgcn-amd-amdhsa--gfx950"
.text
.globl standalone__deepnorm__sampling_kernel
.p2align 8
.type standalone__deepnorm__sampling_kernel,@function
standalone__deepnorm__sampling_kernel:
  s_load_dwordx2 s[16:17], s[0:1], 0
  s_load_dwordx2 s[20:21], s[0:1], 8
  s_cmpk_ge_u32 s2, 256
  s_cbranch_scc1 L_end
  v_readfirstlane_b32 s42, v0
  v_and_b32 v61, 63, v0
  v_lshlrev_b32 v1, 4, v61
  v_cmp_gt_u32 vcc, 56, v61
  v_bfrev_b32 v5, 1
  s_lshr_b32 s42, s42, 6
  v_cndmask_b32 v1, v5, v1, vcc
  s_mov_b32 s18, 29360128
  s_mov_b32 s19, 0x20000
  s_mov_b64 s[22:23], s[18:19]
  s_lshl4_add_u32 s3, s2, s42
  s_addk_i32 s3, 28672
  s_mul_i32 s48, s3, 896
  s_lshl_b32 s39, s42, 8
  s_or_b32 s39, s39, s2
  s_cmp_lt_u32 s39, 30
  s_cbranch_scc1 L_probe
  s_waitcnt lgkmcnt(0)
  buffer_load_dwordx4 v[40:43], v1, s[16:19], s48 offen nt
  buffer_load_dwordx4 v[44:47], v1, s[20:23], s48 offen nt
  s_load_dwordx8 s[8:15], s[0:1], 32
  s_load_dwordx2 s[28:29], s[0:1], 16
  s_load_dwordx2 s[32:33], s[0:1], 24
  s_waitcnt lgkmcnt(0)
  s_branch L_setup
L_probe:
  s_load_dwordx8 s[8:15], s[0:1], 32
  s_load_dwordx2 s[28:29], s[0:1], 16
  s_load_dwordx2 s[32:33], s[0:1], 24
  s_mul_i32 s37, s2, 43
  s_lshr_b32 s37, s37, 8
  s_mul_i32 s37, s37, 6
  s_sub_u32 s37, s2, s37
  s_cmp_ge_u32 s37, 3
  s_cselect_b32 s38, 3, 0
  s_cselect_b32 s39, 2, 1
  s_sub_u32 s38, s37, s38
  s_lshl_b32 s39, s39, 23
  s_mul_i32 s40, s2, 0x3b500
  s_and_b32 s40, s40, 0x3fff00
  s_add_u32 s40, s40, s39
  s_xor_b32 s41, s40, 0x2000
  s_cmp_eq_u32 s38, 1
  s_waitcnt lgkmcnt(0)
  s_cselect_b64 s[6:7], s[16:17], s[20:21]
  s_cmp_eq_u32 s38, 0
  s_cselect_b64 s[6:7], s[10:11], s[6:7]
  s_load_dword s56, s[6:7], s40 glc
  s_load_dword s57, s[6:7], s41 glc
  s_getreg_b32 s44, hwreg(HW_REG_XCC_ID, 0, 3)
  s_and_b32 s45, s6, 0x1fffff
  s_add_u32 s40, s40, s45
  s_lshr_b32 s45, s40, 8
  s_xor_b32 s45, s45, s40
  s_waitcnt lgkmcnt(1)
  s_lshr_b32 s45, s45, 11
  s_xor_b32 s45, s45, s44
  s_bfe_u32 s45, s45, 0x10002
  s_or_b32 s44, s44, 8
  s_lshl_b32 s44, s44, 27
  s_cmp_eq_u32 s2, 0
  s_cselect_b32 s44, s44, 0
  s_mul_i32 s37, s37, 3
  s_lshl_b32 s37, 1, s37
  s_getreg_b32 s39, hwreg(HW_REG_IB_STS, 8, 1)
  s_cmp_eq_u32 s39, s45
  s_cselect_b32 s40, s37, 0
  s_cselect_b32 s41, 0, s37
  s_or_b32 s41, s41, s44
  s_atomic_add_x2 s[40:41], s[12:13], 0
  buffer_load_dwordx4 v[40:43], v1, s[16:19], s48 offen nt
  buffer_load_dwordx4 v[44:47], v1, s[20:23], s48 offen nt
L_setup:
  s_movk_i32 s30, 896
  s_mov_b32 s31, s19
  s_mov_b64 s[34:35], s[30:31]
  v_mov_b32 v6, 0
  global_load_ushort v60, v6, s[8:9]
  buffer_load_dwordx4 v[20:23], v1, s[28:31], 0 offen
  buffer_load_dwordx4 v[28:31], v1, s[32:35], 0 offen
  v_lshlrev_b32 v4, 4, v0
  s_mov_b64 s[4:5], 0xffff
  v_lshlrev_b64 v[4:5], v4, s[4:5]
  v_and_b32 v8, 0x3f803f80, v4
  v_and_b32 v9, 0x3f803f80, v5
  s_mov_b64 s[24:25], s[10:11]
  s_mov_b64 s[26:27], s[18:19]
  s_mov_b32 s45, -3670016
  s_add_u32 s49, s48, s45
  v_mov_b32 v3, 0x3b124925
  v_cndmask_b32 v2, 0, -v3, vcc
  s_andn2_b32 s3, s3, 64
  s_addk_i32 s3, -8192
  s_mulk_i32 s3, 896
  s_mov_b32 s36, 8
  s_mov_b32 s43, 0
  s_bfe_i32 s44, s2, 0x10002
  s_mov_b32 s46, 0xa22151
  s_mov_b32 s38, 0xffff0000
  s_mov_b32 s62, 0
  s_lshl_b32 s39, s42, 8
  s_or_b32 s39, s39, s2
  s_cmp_eq_u32 s39, 31
  s_cbranch_scc0 L_noinit
  v_mul_u32_u24 v7, 8704, v61
  s_add_u32 s40, s14, 4352
  s_addc_u32 s41, s15, 0
  global_store_dword v7, v6, s[14:15] sc1
  global_store_dword v7, v6, s[40:41] sc1
  s_mov_b32 s58, 1
  s_waitcnt vmcnt(0)
  s_atomic_or s58, s[12:13], 128
L_noinit:
  s_waitcnt vmcnt(0)
  v_lshl_or_b32 v60, v60, 16, v60
  v_and_b32 v10, v60, v4
  v_and_b32 v11, v60, v5
  v_lshlrev_b32 v16, 16, v20
  v_and_b32 v17, s38, v20
  v_lshlrev_b32 v18, 16, v21
  v_and_b32 v19, s38, v21
  v_lshlrev_b32 v20, 16, v22
  v_and_b32 v21, s38, v22
  v_lshlrev_b32 v22, 16, v23
  v_and_b32 v23, s38, v23
  v_lshlrev_b32 v24, 16, v28
  v_and_b32 v25, s38, v28
  v_lshlrev_b32 v26, 16, v29
  v_and_b32 v27, s38, v29
  v_lshlrev_b32 v28, 16, v30
  v_and_b32 v29, s38, v30
  v_lshlrev_b32 v30, 16, v31
  v_and_b32 v31, s38, v31
L_loop:
  v_mfma_f32_4x4x4_16b_bf16 v[32:35], v[8:9], v[44:45], 0
  v_mfma_f32_4x4x4_16b_bf16 v[36:39], v[8:9], v[46:47], 0
  s_cmp_eq_u32 s36, 1
  v_mfma_f32_4x4x4_16b_bf16 v[32:35], v[10:11], v[40:41], v[32:35]
  v_mfma_f32_4x4x4_16b_bf16 v[36:39], v[10:11], v[42:43], v[36:39]
  s_cbranch_scc1 L_last
  buffer_load_dwordx4 v[40:43], v1, s[16:19], s49 offen nt
  buffer_load_dwordx4 v[44:47], v1, s[20:23], s49 offen nt
L_last:
  s_nop 2
  v_pk_add_f32 v[4:5], v[32:33], v[34:35]
  v_pk_add_f32 v[12:13], v[36:37], v[38:39]
  v_pk_add_f32 v[12:13], v[12:13], v[4:5]
  v_add_f32 v12, v12, v13
  s_nop 1
  v_add_f32_dpp v12, v12, v12 quad_perm:[1,0,3,2] row_mask:0xf bank_mask:0xf
  s_nop 1
  v_add_f32_dpp v12, v12, v12 quad_perm:[2,3,0,1] row_mask:0xf bank_mask:0xf
  s_nop 1
  v_add_f32_dpp v12, v12, v12 row_half_mirror row_mask:0xf bank_mask:0xf
  s_nop 1
  v_add_f32_dpp v12, v12, v12 row_mirror row_mask:0xf bank_mask:0xf
  s_nop 1
  v_add_f32_dpp v12, v12, v12 row_bcast:15 row_mask:0xa bank_mask:0xf
  s_nop 1
  v_add_f32_dpp v12, v12, v12 row_bcast:31 row_mask:0xc bank_mask:0xf
  s_nop 0
  v_readlane_b32 s4, v12, 63
  s_nop 1
  v_pk_fma_f32 v[32:33], v[2:3], s[4:5], v[32:33] op_sel_hi:[0,0,1]
  v_pk_fma_f32 v[34:35], v[2:3], s[4:5], v[34:35] op_sel_hi:[0,0,1]
  v_pk_fma_f32 v[36:37], v[2:3], s[4:5], v[36:37] op_sel_hi:[0,0,1]
  v_pk_fma_f32 v[38:39], v[2:3], s[4:5], v[38:39] op_sel_hi:[0,0,1]
  v_pk_mul_f32 v[12:13], v[32:33], v[32:33]
  v_pk_fma_f32 v[12:13], v[34:35], v[34:35], v[12:13]
  v_pk_fma_f32 v[12:13], v[36:37], v[36:37], v[12:13]
  v_pk_fma_f32 v[12:13], v[38:39], v[38:39], v[12:13]
  v_add_f32 v12, v12, v13
  v_pk_mul_f32 v[32:33], v[32:33], v[16:17]
  v_pk_mul_f32 v[34:35], v[34:35], v[18:19]
  v_add_f32_dpp v12, v12, v12 quad_perm:[1,0,3,2] row_mask:0xf bank_mask:0xf
  v_pk_mul_f32 v[36:37], v[36:37], v[20:21]
  v_pk_mul_f32 v[38:39], v[38:39], v[22:23]
  v_add_f32_dpp v12, v12, v12 quad_perm:[2,3,0,1] row_mask:0xf bank_mask:0xf
  s_nop 1
  v_add_f32_dpp v12, v12, v12 row_half_mirror row_mask:0xf bank_mask:0xf
  s_nop 1
  v_add_f32_dpp v12, v12, v12 row_mirror row_mask:0xf bank_mask:0xf
  s_nop 1
  v_add_f32_dpp v12, v12, v12 row_bcast:15 row_mask:0xa bank_mask:0xf
  s_nop 1
  v_add_f32_dpp v12, v12, v12 row_bcast:31 row_mask:0xc bank_mask:0xf
  v_fmaak_f32 v12, v12, v3, 0x3727c5ac
  v_rsq_f32 v12, v12
  s_nop 0
  v_readlane_b32 s4, v12, 63
  s_nop 1
  v_pk_fma_f32 v[32:33], v[32:33], s[4:5], v[24:25] op_sel_hi:[1,0,1]
  v_pk_fma_f32 v[34:35], v[34:35], s[4:5], v[26:27] op_sel_hi:[1,0,1]
  v_pk_fma_f32 v[36:37], v[36:37], s[4:5], v[28:29] op_sel_hi:[1,0,1]
  v_pk_fma_f32 v[38:39], v[38:39], s[4:5], v[30:31] op_sel_hi:[1,0,1]
  s_bitcmp1_b32 s46, 0
  v_cvt_pk_bf16_f32 v32, v32, v33
  v_cvt_pk_bf16_f32 v33, v34, v35
  v_cvt_pk_bf16_f32 v34, v36, v37
  v_cvt_pk_bf16_f32 v35, v38, v39
  s_cbranch_scc1 L_hold
  buffer_store_dwordx4 v[32:35], v1, s[24:27], s48 offen sc1
  s_sub_u32 s36, s36, 1
  s_cmp_eq_u32 s36, 0
  s_cbranch_scc1 L_done
  s_bitcmp1_b32 s46, 1
  s_cbranch_scc1 L_release
  s_cmp_eq_u32 s62, 1
  s_cbranch_scc0 L_have
  s_mov_b32 s58, 1
  s_atomic_add s58, s[14:15], s59 glc
L_take:
  s_mov_b32 s48, s49
  s_waitcnt lgkmcnt(0)
  s_cmp_lt_u32 s58, 32
  s_cselect_b32 s36, 2, 1
  s_and_b32 s38, s58, 28
  s_lshl_b32 s38, s38, 7
  s_and_b32 s39, s58, 3
  s_lshl4_add_u32 s38, s39, s38
  s_add_u32 s38, s38, s60
  s_bitcmp1_b32 s61, s58
  s_cselect_b32 s39, 64, 0
  s_add_u32 s38, s38, s39
  s_mul_i32 s49, s38, 896
  s_cmp_lg_u32 s46, 0
  s_mov_b32 s46, 0
  s_waitcnt vmcnt(2)
  s_cbranch_scc1 L_loop
  s_waitcnt vmcnt(1)
  s_branch L_loop
L_release:
  buffer_store_dwordx4 v[48:51], v1, s[24:27], s50 offen sc1
  s_bitcmp1_b32 s46, 3
  s_cbranch_scc0 L_more
  s_waitcnt lgkmcnt(0)
  s_mov_b32 s62, s63
  s_cmp_eq_u32 s62, 1
  s_cbranch_scc0 L_more
  s_mov_b32 s58, 1
  s_atomic_add s58, s[14:15], s59 glc
  s_barrier
  s_branch L_take
L_more:
  s_load_dword s63, s[12:13], 128
  s_mov_b32 s50, s51
  s_mov_b32 s51, s52
  s_mov_b32 s48, s49
  s_bitcmp1_b32 s44, 0
  s_cselect_b32 s38, 57344, 0
  s_add_u32 s49, s38, s3
  s_ashr_i32 s44, s44, 1
  s_xor_b32 s45, s45, s43
  s_add_u32 s3, s3, s45
  s_lshr_b32 s46, s46, 4
  v_mov_b64 v[48:49], v[52:53]
  v_mov_b64 v[50:51], v[54:55]
  v_mov_b64 v[52:53], v[56:57]
  v_mov_b64 v[54:55], v[58:59]
  s_barrier
  s_waitcnt vmcnt(2)
  s_branch L_loop
L_hold:
  v_mov_b64 v[58:59], v[54:55]
  v_mov_b64 v[56:57], v[52:53]
  v_mov_b64 v[54:55], v[50:51]
  v_mov_b64 v[52:53], v[48:49]
  v_mov_b64 v[48:49], v[32:33]
  v_mov_b64 v[50:51], v[34:35]
  s_mov_b32 s52, s51
  s_mov_b32 s51, s50
  s_mov_b32 s50, s48
  s_sub_u32 s36, s36, 1
  s_bitcmp1_b32 s46, 2
  s_cbranch_scc0 L_have
  s_load_dwordx2 s[54:55], s[12:13], 0
  s_add_u32 s38, s3, 448
  v_mul_i32_i24 v4, s45, v61
  v_add_u32 v4, s38, v4
  s_bfe_u32 s59, s2, 0x20003
  s_lshl_b32 s60, s59, 7
  s_add_u32 s60, s60, s42
  v_and_b32 v5, 28, v61
  v_and_b32 v6, 3, v61
  v_lshl_add_u32 v5, v5, 3, v6
  v_lshl_add_u32 v5, v5, 4, s60
  v_cmp_lt_u32 vcc, 31, v61
  v_mul_u32_u24 v5, 896, v5
  v_add_u32 v5, 448, v5
  v_cndmask_b32 v4, v4, v5, vcc
  v_lshrrev_b32 v5, 24, v4
  v_mad_u32_u24 v5, v5, 9, 2
  s_and_b32 s38, s24, 0x1fffff
  v_add_u32 v12, s38, v4
  v_lshrrev_b32 v6, 8, v12
  v_xor_b32 v12, v12, v6
  v_lshrrev_b32 v12, 13, v12
  s_and_b32 s38, s16, 0x1fffff
  v_add_u32 v13, s38, v4
  v_lshrrev_b32 v6, 8, v13
  v_xor_b32 v13, v13, v6
  v_lshrrev_b32 v13, 13, v13
  s_and_b32 s38, s20, 0x1fffff
  v_add_u32 v14, s38, v4
  v_lshrrev_b32 v6, 8, v14
  v_xor_b32 v14, v14, v6
  v_lshrrev_b32 v14, 13, v14
  s_mov_b32 s37, 0
  s_waitcnt lgkmcnt(0)
L_poll:
  s_add_u32 s44, s54, 0x9249
  s_add_u32 s38, s55, 0x9249
  s_or_b32 s38, s38, s44
  s_andn2_b32 s38, 0x40024924, s38
  s_cbranch_scc1 L_retry
  v_lshrrev_b32 v5, v5, s44
  s_lshr_b32 s39, s55, 27
  s_add_u32 s39, s39, s2
  s_bfe_u32 s39, s39, 0x10002
  v_lshrrev_b32 v6, 3, v5
  v_lshrrev_b32 v7, 6, v5
  v_xor_b32 v12, v12, v5
  v_xor_b32 v13, v13, v6
  v_xor_b32 v14, v14, v7
  v_bitop3_b32 v12, v12, v13, v14 bitop3:0xe8
  v_and_b32 v12, 1, v12
  v_cmp_ne_u32 vcc, s39, v12
  s_lshl1_add_u32 s59, s59, s39
  s_lshl4_add_u32 s59, s59, s42
  s_mulk_i32 s59, 4352
  s_mov_b32 s44, vcc_lo
  s_mov_b32 s61, vcc_hi
L_have:
  s_mov_b32 s48, s49
  s_bitcmp1_b32 s44, 0
  s_cselect_b32 s38, 57344, 0
  s_add_u32 s49, s38, s3
  s_ashr_i32 s44, s44, 1
  s_xor_b32 s45, s45, s43
  s_add_u32 s3, s3, s45
  s_lshr_b32 s46, s46, 4
  s_waitcnt vmcnt(0)
  s_branch L_loop
L_retry:
  s_add_u32 s37, s37, 1
  s_cmp_gt_u32 s37, 64
  s_cbranch_scc1 L_alone
  v_mov_b32 v60, 0
  global_load_dwordx2 v[6:7], v60, s[12:13] sc1
  s_waitcnt vmcnt(0)
  v_readfirstlane_b32 s54, v6
  v_readfirstlane_b32 s55, v7
  s_branch L_poll
L_alone:
  s_mov_b32 s44, 0xaaaaaaaa
  s_mov_b32 s43, s45
  s_add_u32 s36, s36, 5
  s_and_b32 s46, s46, 0x77777
  s_branch L_have
L_done:
L_end:
  s_endpgm
.section .rodata,"a"
.p2align 6
.amdhsa_kernel standalone__deepnorm__sampling_kernel
  .amdhsa_next_free_vgpr 62
  .amdhsa_next_free_sgpr 64
  .amdhsa_accum_offset 64
  .amdhsa_group_segment_fixed_size 0
  .amdhsa_kernarg_size 64
  .amdhsa_user_sgpr_count 2
  .amdhsa_user_sgpr_kernarg_segment_ptr 1
  .amdhsa_system_sgpr_workgroup_id_x 1
  .amdhsa_float_denorm_mode_32 3
.end_amdhsa_kernel
```
